```python
import torch

def _softmax(x, axis=-1):
    return torch.softmax(x, dim=axis)

def _gelu(x):
    return torch.nn.functional.gelu(x, approximate='tanh')

def _silu(x):
    return torch.nn.functional.silu(x)

def _sigmoid(x):
    return torch.sigmoid(x)

def _layernorm(x, axis=-1, eps=1e-05):
    m = x.mean(dim=axis, keepdim=True)
    v = x.var(dim=axis, keepdim=True, unbiased=False)
    return (x - m) / torch.sqrt(v + eps)

def _scatter_add(tgt, idx, src, axis=0):
    return tgt.clone().index_add_(axis, idx, src)

def _segment_sum(src, seg, n):
    out = torch.zeros((n,) + src.shape[1:], dtype=src.dtype)
    return out.index_add_(0, seg, src)

def _pad(x, pw):
    flat = tuple((v for pair in reversed(pw) for v in pair))
    return torch.nn.functional.pad(x, flat)
kernel_name = 'gather_scatter__tensor_product_equiv_tfn__graph'

def setup_inputs():

    _w = lambda a: (lambda t: t.to(torch.bfloat16) if t.is_floating_point() else t)(torch.as_tensor(a))
    N, deg, C, L, DE = (10000, 16, 128, 1, 16)
    E = N * deg
    M = (L + 1) ** 2
    src = (lambda lo, hi, *s: torch.randint(lo, hi, s))(0, N, E).to(torch.int64)
    dst = (lambda lo, hi, *s: torch.randint(lo, hi, s))(0, N, E).to(torch.int64)
    r = (lambda *s: torch.randn(*s, dtype=torch.bfloat16) * 0.05)(E, 3)
    r = r / (torch.linalg.norm(r, dim=-1, keepdim=True) + 1e-09)
    rx, ry, rz = (r[:, 0].clone(), r[:, 1].clone(), r[:, 2].clone())
    Ys = [torch.ones((E, 1), dtype=float)]
    if L >= 1:
        Ys.append(r.to(float))
    if L >= 2:
        Ys.append(torch.stack([2 * rx * ry, 2 * ry * rz, (3 * rz * rz - 1.0) / (lambda _x: torch.sqrt(torch.as_tensor(_x)))(3.0), 2 * rx * rz, rx * rx - ry * ry], dim=-1).to(float))
    for _l in range(3, L + 1):
        Ys.append(((lambda *s: torch.randn(*s, dtype=torch.bfloat16) * 0.05)(E, 2 * _l + 1) * 0.3).to(float))
    Y = torch.cat(Ys, dim=-1)
    cg = torch.zeros((M, M, M), dtype=float)
    off = [_l * _l for _l in range(L + 2)]
    for l1 in range(L + 1):
        for l2 in range(L + 1):
            for l3 in range(abs(l1 - l2), min(L, l1 + l2) + 1):
                d1, d2, d3 = (2 * l1 + 1, 2 * l2 + 1, 2 * l3 + 1)
                cg[off[l1]:off[l1 + 1], off[l2]:off[l2 + 1], off[l3]:off[l3 + 1]] = (lambda *s: torch.randn(*s, dtype=torch.bfloat16) * 0.05)(d1, d2, d3) / (lambda _x: torch.sqrt(torch.as_tensor(_x)))(float(d1 * d2))
    return {'x': _w((lambda *s: torch.randn(*s, dtype=torch.bfloat16) * 0.05)(N, C, M) * 0.2), 'src': _w(src), 'dst': _w(dst), 'Y': _w(Y), 'edge_feat': _w((lambda *s: torch.randn(*s, dtype=torch.bfloat16) * 0.05)(E, DE)), 'w_rad': _w((lambda *s: torch.randn(*s, dtype=torch.bfloat16) * 0.05)(DE, C) * (1.0 / max(1.0, DE) ** 0.5)), 'cg': _w(cg), 'w_mix': _w((lambda *s: torch.randn(*s, dtype=torch.bfloat16) * 0.05)(C, C) * (1.0 / max(1.0, C) ** 0.5))}

def reference(x, src, dst, Y, edge_feat, w_rad, cg, w_mix):
    N, C, M = (x.shape[0], x.shape[1], x.shape[2])
    R = _silu(edge_feat @ w_rad)
    xs = x[src]
    tp = torch.einsum('eci,ef,ifo->eco', xs, Y, cg)
    msg = R[:, :, None] * tp
    agg = _segment_sum(msg.reshape(-1, C * M), dst, N).reshape(N, C, M)
    return torch.einsum('ncm,cd->ndm', agg, w_mix)
```

```asm
; @launch kernel=bin_kernel grid=(256,1,1) block=(640,1,1) lds=12288
; @launch kernel=main_kernel grid=(256,1,1) block=(512,1,1) lds=104704
.amdgcn_target "amdgcn-amd-amdhsa--gfx950"
.text
.globl bin_kernel
.p2align 8
.type bin_kernel,@function
bin_kernel:
    s_cmp_ge_u32 s2, 256
    s_cbranch_scc1 K1_END
    s_load_dwordx4 s[44:47], s[0:1], 0
    s_load_dwordx4 s[48:51], s[0:1], 16
    s_load_dwordx4 s[52:55], s[0:1], 32
    s_load_dwordx4 s[56:59], s[0:1], 48
    s_load_dwordx2 s[60:61], s[0:1], 80
    v_and_b32 v1, 63, v0
    v_lshlrev_b32 v2, 2, v0
    v_lshrrev_b32 v23, 6, v0
    v_mov_b32 v22, 1
    v_readfirstlane_b32 s4, v23
    v_mov_b32 v23, 0
    v_lshlrev_b32 v33, 4, v1
    v_cmp_gt_u32 vcc, 256, v0
    s_and_saveexec_b64 s[6:7], vcc
    s_cbranch_execz K1_Z
    ds_write_b32 v2, v23
K1_Z:
    s_mov_b64 exec, s[6:7]
    s_mul_i32 s5, s2, 625
    v_add_u32 v3, s5, v0
    s_waitcnt lgkmcnt(0)
    s_mov_b32 s8, s48
    s_and_b32 s9, s49, 0xffff
    s_mov_b32 s10, 0x9c400
    s_mov_b32 s11, 0x20000
    s_mov_b32 s12, s46
    s_and_b32 s13, s47, 0xffff
    s_mov_b32 s14, 0x9c400
    s_mov_b32 s15, 0x20000
    s_mov_b32 s16, s50
    s_and_b32 s17, s51, 0xffff
    s_mov_b32 s18, 0x138800
    s_mov_b32 s19, 0x20000
    s_mov_b32 s24, s60
    s_and_b32 s25, s61, 0xffff
    s_mov_b32 s26, 0x850000
    s_mov_b32 s27, 0x20000
    v_mov_b32 v35, 0x7ffffff0
    s_cmp_eq_u32 s4, 9
    s_cbranch_scc1 K1_PA
    s_cmp_eq_u32 s4, 8
    s_cbranch_scc0 K1_PDONE
    s_cmp_lt_u32 s2, 32
    s_cbranch_scc1 K1_PB
    s_cmp_eq_u32 s2, 32
    s_cbranch_scc0 K1_PDONE
    s_mov_b32 s32, s56
    s_and_b32 s33, s57, 0xffff
    s_mov_b32 s34, 0x80
    s_mov_b32 s35, 0x20000
    v_bfe_u32 v23, v1, 2, 2
    v_lshlrev_b32 v23, 4, v23
    v_and_b32 v37, 3, v1
    v_lshl_add_u32 v23, v37, 2, v23
    v_lshrrev_b32 v37, 4, v1
    v_add_lshl_u32 v23, v23, v37, 1
    buffer_load_ushort v34, v23, s[32:35], 0 offen
    v_lshlrev_b32 v35, 1, v1
    v_add_u32 v35, 0x841000, v35
    s_branch K1_PDONE
K1_PB:
    s_mov_b32 s32, s54
    s_and_b32 s33, s55, 0xffff
    s_mov_b32 s34, 0x1000
    s_mov_b32 s35, 0x20000
    s_lshl_b32 s5, s2, 6
    v_add_u32 v35, s5, v1
    v_lshrrev_b32 v23, 3, v35
    v_bfe_u32 v37, v23, 5, 1
    v_lshlrev_b32 v37, 3, v37
    v_and_b32 v36, 7, v35
    v_add_u32 v37, v37, v36
    v_lshlrev_b32 v37, 7, v37
    v_and_b32 v36, 31, v23
    v_lshl_add_u32 v37, v36, 1, v37
    v_bfe_u32 v36, v23, 6, 1
    v_lshl_add_u32 v37, v36, 6, v37
    v_bfe_u32 v36, v23, 7, 1
    v_add_lshl_u32 v37, v37, v36, 1
    buffer_load_ushort v34, v37, s[32:35], 0 offen
    v_lshlrev_b32 v35, 1, v35
    v_add_u32 v35, 0x840000, v35
    s_branch K1_PDONE
K1_PA:
    s_mov_b32 s32, s58
    s_and_b32 s33, s59, 0xffff
    s_mov_b32 s34, 0x8000
    s_mov_b32 s35, 0x20000
    s_lshl_b32 s5, s2, 6
    v_add_u32 v35, s5, v1
    v_lshrrev_b32 v23, 3, v35
    v_bfe_u32 v37, v23, 6, 2
    v_lshlrev_b32 v37, 5, v37
    v_bfe_u32 v36, v23, 4, 2
    v_lshl_add_u32 v37, v36, 3, v37
    v_and_b32 v36, 7, v35
    v_add_u32 v37, v37, v36
    v_lshlrev_b32 v37, 7, v37
    v_and_b32 v36, 15, v23
    v_lshl_add_u32 v37, v36, 1, v37
    v_lshrrev_b32 v36, 9, v23
    v_lshl_add_u32 v37, v36, 5, v37
    v_bfe_u32 v36, v23, 8, 1
    v_add_lshl_u32 v37, v37, v36, 1
    buffer_load_ushort v34, v37, s[32:35], 0 offen
    v_lshlrev_b32 v35, 1, v35
    v_add_u32 v35, 0x842000, v35
K1_PDONE:
    v_lshlrev_b32 v4, 2, v3
    buffer_load_dword v5, v4, s[8:11], 0 offen
    buffer_load_dword v6, v4, s[12:15], 0 offen
    v_lshlrev_b32 v4, 3, v3
    s_waitcnt lgkmcnt(0)
    s_barrier
    s_cmp_lt_u32 s2, 16
    s_cbranch_scc0 K1_NOCPF
    s_cmp_ge_u32 s4, 8
    s_cbranch_scc0 K1_NOCPF
    s_getpc_b64 s[64:65]
K1_PC:
    s_add_u32 s64, s64, main_kernel-K1_PC
    s_addc_u32 s65, s65, 0
    v_and_b32 v36, 63, v0
    s_sub_u32 s5, s4, 8
    s_lshl_b32 s5, s5, 6
    v_add_u32 v36, s5, v36
    v_min_u32 v36, (K2_CODE_END-main_kernel)/128, v36
    v_lshlrev_b32 v36, 7, v36
    global_load_dword v43, v36, s[64:65]
K1_NOCPF:
    buffer_load_dwordx2 v[8:9], v4, s[16:19], 0 offen
    v_cmp_gt_u32 vcc, 625, v0
    s_and_saveexec_b64 s[6:7], vcc
    s_waitcnt vmcnt(2)
    v_and_b32 v20, 7, v5
    v_bfe_u32 v23, v5, 3, 5
    v_lshl_or_b32 v20, v20, 5, v23
    v_lshlrev_b32 v20, 2, v20
    ds_add_rtn_u32 v21, v20, v22
    s_mov_b64 exec, s[6:7]
    s_waitcnt lgkmcnt(0)
    s_barrier
    ds_read_b128 v[24:27], v33 offset:0
    s_waitcnt lgkmcnt(0)
    v_add_u32 v30, v24, v25
    v_add_u32 v31, v30, v26
    v_add_u32 v32, v31, v27
    v_mov_b32 v28, v32
    s_nop 1
    v_add_u32_dpp v32, v32, v32 row_shr:1 row_mask:0xf bank_mask:0xf
    s_nop 1
    v_add_u32_dpp v32, v32, v32 row_shr:2 row_mask:0xf bank_mask:0xf
    s_nop 1
    v_add_u32_dpp v32, v32, v32 row_shr:4 row_mask:0xf bank_mask:0xf
    s_nop 1
    v_add_u32_dpp v32, v32, v32 row_shr:8 row_mask:0xf bank_mask:0xf
    s_nop 1
    v_add_u32_dpp v32, v32, v32 row_bcast:15 row_mask:0xa bank_mask:0xf
    s_nop 1
    v_add_u32_dpp v32, v32, v32 row_bcast:31 row_mask:0xc bank_mask:0xf
    s_nop 0
    v_sub_u32 v28, v32, v28
    v_add_u32 v29, v28, v24
    v_add_u32 v30, v28, v30
    v_add_u32 v31, v28, v31
    ds_write_b128 v33, v[28:31] offset:1024
    v_lshl_or_b32 v24, v24, 16, v28
    v_lshl_or_b32 v25, v25, 16, v29
    v_lshl_or_b32 v26, v26, 16, v30
    v_lshl_or_b32 v27, v27, 16, v31
    s_cmp_eq_u32 s4, 0
    s_cbranch_scc0 K1_NTAB
    v_lshrrev_b32 v23, 3, v1
    v_lshlrev_b32 v23, 15, v23
    v_bfe_u32 v37, v1, 1, 2
    v_lshl_add_u32 v23, v37, 10, v23
    v_and_b32 v37, 1, v1
    v_lshl_add_u32 v23, v37, 4, v23
    s_and_b32 s5, s2, 7
    s_lshl_b32 s5, s5, 12
    s_lshr_b32 s63, s2, 5
    s_lshl_b32 s63, s63, 7
    s_add_u32 s5, s5, s63
    s_bfe_u32 s63, s2, 0x20003
    s_lshl_b32 s63, s63, 5
    s_add_u32 s5, s5, s63
    s_add_u32 s5, s5, 0x800000
    buffer_store_dwordx4 v[24:27], v23, s[24:27], s5 offen
K1_NTAB:
    v_cmp_gt_u32 vcc, 625, v0
    s_waitcnt lgkmcnt(0)
    s_and_saveexec_b64 s[6:7], vcc
    ds_read_b32 v23, v20 offset:1024
    s_mul_i32 s5, s2, 625
    v_lshrrev_b32 v37, 8, v5
    s_nop 0
    s_cmp_lt_u32 s4, 1
    s_cbranch_scc1 K1_W1
    s_waitcnt vmcnt(0)
    s_branch K1_W2
K1_W1:
    s_waitcnt vmcnt(1)
K1_W2:
    v_lshl_or_b32 v10, v37, 14, v6
    v_mov_b32 v11, v3
    s_waitcnt lgkmcnt(0)
    v_add_u32 v23, v23, v21
    v_lshlrev_b32 v37, 4, v23
    ds_write_b128 v37, v[8:11] offset:2048
    v_lshlrev_b32 v23, 4, v0
    s_mul_i32 s5, s2, 10000
    s_add_u32 s5, s5, 0x0
    s_waitcnt lgkmcnt(0)
    s_barrier
    ds_read_b128 v[8:11], v23 offset:2048
    s_waitcnt lgkmcnt(0)
    buffer_store_dwordx4 v[8:11], v23, s[24:27], s5 offen
    s_mov_b64 exec, s[6:7]
K1_STORED:
    s_cmp_eq_u32 s4, 0
    s_cbranch_scc0 K1_NT
K1_NT:
    s_cmp_eq_u32 s4, 9
    s_cbranch_scc1 K1_PS16
    s_cmp_eq_u32 s4, 8
    s_cbranch_scc0 K1_END
    s_cmp_lt_u32 s2, 32
    s_cbranch_scc1 K1_PSR
    s_cmp_eq_u32 s2, 32
    s_cbranch_scc0 K1_END
    s_branch K1_PS16
K1_PSR:
K1_PS16:
    buffer_store_short v34, v35, s[24:27], 0 offen
K1_END:
    s_endpgm
.globl main_kernel
.p2align 8
.type main_kernel,@function
main_kernel:
    s_cmp_ge_u32 s2, 256
    s_cbranch_scc1 K2_END
    s_load_dwordx2 s[42:43], s[0:1], 80
    s_load_dwordx2 s[44:45], s[0:1], 0
    s_load_dwordx2 s[46:47], s[0:1], 64
    s_load_dwordx2 s[74:75], s[0:1], 32
    v_lshrrev_b32 v4, 6, v0
    v_and_b32 v1, 63, v0
    v_readfirstlane_b32 s4, v4
    v_lshlrev_b32 v2, 4, v1
    v_and_b32 v3, 15, v1
    s_mov_b32 s5, s2
    s_and_b32 s6, s2, 7
    s_lshl_b32 s6, s6, 5
    s_lshr_b32 s27, s2, 3
    s_or_b32 s6, s6, s27
    v_and_b32 v136, 31, v1
    s_lshl_b32 s27, s4, 5
    v_add_u32 v136, s27, v136
    v_and_b32 v4, 7, v1
    v_lshlrev_b32 v4, 12, v4
    v_bfe_u32 v5, v1, 3, 2
    v_lshl_add_u32 v4, v5, 5, v4
    s_and_b32 s27, s2, 7
    s_lshl_b32 s27, s27, 15
    s_lshr_b32 s28, s2, 6
    s_lshl_b32 s28, s28, 10
    s_add_u32 s27, s27, s28
    s_bfe_u32 s28, s2, 0x30003
    s_lshl_b32 s28, s28, 2
    s_add_u32 s27, s27, s28
    s_lshl_b32 s28, s4, 7
    s_add_u32 s27, s27, s28
    s_add_u32 s27, s27, 0x800000
    s_lshl_b32 s28, s4, 10
    s_add_u32 s28, s28, 0x840000
    s_cmp_lt_u32 s4, 5
    s_cselect_b32 s28, s28, 0x7ff00000
    s_cmp_eq_u32 s4, 4
    s_cselect_b32 s29, 8, 64
    v_cmp_gt_u32 vcc, s29, v1
    v_mov_b32 v6, 0x7ff00000
    s_nop 0
    v_cndmask_b32 v6, v6, v2, vcc
    s_waitcnt lgkmcnt(0)
    s_mov_b32 s12, s42
    s_and_b32 s13, s43, 0xffff
    s_mov_b32 s14, 0x850000
    s_mov_b32 s15, 0x20000
    buffer_load_dword v137, v4, s[12:15], s27 offen
    buffer_load_dwordx4 v[140:143], v6, s[12:15], s28 offen
    s_lshr_b32 s27, s2, 3
    s_add_u32 s28, s4, 0
    s_lshl_b32 s28, s28, 5
    s_add_u32 s27, s27, s28
    s_lshl_b32 s27, s27, 13
    s_cmp_lt_u32 s4, 1
    s_cselect_b32 s27, s27, 0x7ff00000
    v_lshlrev_b32 v4, 7, v1
    s_mov_b32 s8, s44
    s_and_b32 s9, s45, 0xffff
    s_mov_b32 s10, 0x9c4000
    s_mov_b32 s11, 0x20000
    buffer_load_dword v19, v4, s[8:11], s27 offen
    s_mov_b32 s16, s46
    s_and_b32 s17, s47, 0xffff
    s_mov_b32 s18, 0x9c4000
    s_mov_b32 s19, 0x20000
    s_mov_b32 s76, s74
    s_and_b32 s77, s75, 0xffff
    s_mov_b32 s78, 0x4e2000
    s_mov_b32 s79, 0x20000
    v_mov_b32 v5, 0
    v_lshlrev_b32 v6, 2, v0
    v_and_b32 v7, 0x400, v6
    v_add_u32 v6, v6, v7
    ds_write_b32 v6, v5
    s_mov_b32 s30, 0x0f0f0f0f
    s_mov_b32 s31, 0x0f0f0f0f
    s_mov_b32 s32, 0xf0f0f0f0
    s_mov_b32 s33, 0xf0f0f0f0
    s_mov_b32 s34, 0xbfb8aa3b
    s_mov_b32 s35, 0xbfb8aa3b
    s_mov_b32 s20, 0
    s_mov_b32 s65, 0
    s_waitcnt lgkmcnt(0)
    s_barrier
    s_waitcnt vmcnt(1)
    v_lshrrev_b32 v139, 16, v137
    v_mov_b32 v8, 625
    v_and_b32 v7, 0xffff, v137
    v_mov_b32 v5, v139
    v_mad_u32_u24 v7, v136, v8, v7
    s_nop 1
    v_add_u32_dpp v139, v139, v139 row_shr:1 row_mask:0xf bank_mask:0xf
    s_nop 1
    v_add_u32_dpp v139, v139, v139 row_shr:2 row_mask:0xf bank_mask:0xf
    s_nop 1
    v_add_u32_dpp v139, v139, v139 row_shr:4 row_mask:0xf bank_mask:0xf
    s_nop 1
    v_add_u32_dpp v139, v139, v139 row_shr:8 row_mask:0xf bank_mask:0xf
    s_nop 1
    v_add_u32_dpp v139, v139, v139 row_bcast:15 row_mask:0xa bank_mask:0xf
    s_nop 0
    v_sub_u32 v6, v139, v5
    v_readlane_b32 s7, v139, 31
K2_ROUND:
    s_lshl_b32 s27, s20, 7
    s_lshl_b32 s28, s4, 9
    v_sub_u32 v136, s27, v6
    s_add_u32 s28, s28, 4096
    v_add_u32 v137, 128, v136
    v_max_i32 v138, 0, v136
    v_lshrrev_b32 v4, 5, v1
    v_min_i32 v137, v137, v5
    v_add_u32 v138, v138, v4
    v_add_u32 v139, v7, v138
    v_sub_u32 v137, v137, v138
    v_sub_u32 v138, v138, v136
    v_lshl_add_u32 v138, v138, 2, s28
    v_cmp_lt_i32 vcc, 0, v137
    s_and_b64 exec, exec, vcc
    ds_write_b32 v138, v139 offset:0
    v_cmp_lt_i32 vcc, 2, v137
    s_and_b64 exec, exec, vcc
    v_add_u32 v139, 2, v139
    ds_write_b32 v138, v139 offset:8
    v_cmp_lt_i32 vcc, 4, v137
    s_and_b64 exec, exec, vcc
    v_add_u32 v139, 2, v139
    ds_write_b32 v138, v139 offset:16
    v_cmp_lt_i32 vcc, 6, v137
    s_and_b64 exec, exec, vcc
    v_add_u32 v139, 2, v139
    ds_write_b32 v138, v139 offset:24
    v_cmp_lt_i32 vcc, 8, v137
    s_and_b64 exec, exec, vcc
    s_cbranch_scc0 K2_EXPD
    v_add_u32 v137, -8, v137
    v_add_u32 v139, 2, v139
    v_add_u32 v138, 32, v138
K2_EXP:
    v_cmp_lt_i32 vcc, 0, v137
    s_and_b64 exec, exec, vcc
    s_cbranch_scc0 K2_EXPD
    ds_write_b32 v138, v139
    v_add_u32 v137, -2, v137
    v_add_u32 v139, 2, v139
    v_add_u32 v138, 8, v138
    s_branch K2_EXP
K2_EXPD:
    s_mov_b64 exec, -1
    v_lshl_add_u32 v4, v1, 2, s28
    s_sub_i32 s29, s7, s27
    ds_read_b32 v136, v4
    ds_read_b32 v137, v4 offset:256
    v_cmp_gt_i32 s[38:39], s29, v1
    v_add_u32 v4, 64, v1
    v_cmp_gt_i32 s[40:41], s29, v4
    v_mov_b32 v4, 0x7ffffff0
    s_waitcnt lgkmcnt(0)
    v_lshlrev_b32 v136, 4, v136
    v_lshlrev_b32 v137, 4, v137
    v_cndmask_b32 v136, v4, v136, s[38:39]
    v_cndmask_b32 v137, v4, v137, s[40:41]
    buffer_load_dwordx4 v[200:203], v136, s[12:15], 0 offen
    buffer_load_dwordx4 v[204:207], v137, s[12:15], 0 offen
    v_lshrrev_b32 v8, 1, v1
    v_add_u32 v4, 0, v8
    v_cmp_gt_i32 s[42:43], s29, v4
    v_add_u32 v4, 32, v8
    v_cmp_gt_i32 s[44:45], s29, v4
    v_add_u32 v4, 64, v8
    v_cmp_gt_i32 s[46:47], s29, v4
    v_add_u32 v4, 96, v8
    v_cmp_gt_i32 s[36:37], s29, v4
    s_cmp_eq_u32 s20, 0
    s_cbranch_scc0 K2_NOINIT
    s_min_u32 s28, s4, 5
    s_lshl_b32 s28, s28, 10
    s_add_u32 s28, s28, 98560
    v_add_u32 v4, s28, v2
    ds_write_b128 v4, v[140:143]
    s_add_u32 s27, s7, 127
    s_lshr_b32 s27, s27, 7
    v_mov_b32 v8, 2048
    v_mov_b32 v4, s27
    ds_max_u32 v8, v4
    v_mov_b32 v50, 63
    v_writelane_b32 v50, 0, 0
    v_writelane_b32 v50, 1, 1
    v_writelane_b32 v50, 2, 2
    v_writelane_b32 v50, 3, 3
    v_writelane_b32 v50, 4, 4
    v_writelane_b32 v50, 5, 5
    v_writelane_b32 v50, 6, 6
    v_writelane_b32 v50, 8, 7
    v_writelane_b32 v50, 7, 8
    v_writelane_b32 v50, 14, 9
    v_writelane_b32 v50, 13, 10
    v_writelane_b32 v50, 12, 11
    v_writelane_b32 v50, 16, 12
    v_writelane_b32 v50, 11, 13
    v_writelane_b32 v50, 15, 14
    v_writelane_b32 v50, 10, 15
    v_writelane_b32 v50, 23, 16
    v_writelane_b32 v50, 20, 17
    v_writelane_b32 v50, 21, 18
    v_writelane_b32 v50, 22, 19
    v_writelane_b32 v50, 9, 20
    v_writelane_b32 v50, 19, 21
    v_writelane_b32 v50, 18, 22
    v_writelane_b32 v50, 17, 23
    v_writelane_b32 v50, 28, 24
    v_writelane_b32 v50, 29, 25
    v_writelane_b32 v50, 27, 26
    v_writelane_b32 v50, 24, 27
    v_writelane_b32 v50, 31, 28
    v_writelane_b32 v50, 30, 29
    v_writelane_b32 v50, 26, 30
    v_writelane_b32 v50, 25, 31
    v_writelane_b32 v50, 39, 32
    v_writelane_b32 v50, 33, 33
    v_writelane_b32 v50, 34, 34
    v_writelane_b32 v50, 38, 35
    v_writelane_b32 v50, 35, 36
    v_writelane_b32 v50, 37, 37
    v_writelane_b32 v50, 36, 38
    v_writelane_b32 v50, 32, 39
    v_mov_b32 v64, 0
    v_mov_b32 v65, 0
    v_mov_b32 v66, 0
    v_mov_b32 v67, 0
    v_mov_b32 v68, 0
    v_mov_b32 v69, 0
    v_mov_b32 v70, 0
    v_mov_b32 v71, 0
    v_mov_b32 v72, 0
    v_mov_b32 v73, 0
    v_mov_b32 v74, 0
    v_mov_b32 v75, 0
    v_mov_b32 v76, 0
    v_mov_b32 v77, 0
    v_mov_b32 v78, 0
    v_mov_b32 v79, 0
    v_mov_b32 v80, 0
    v_mov_b32 v81, 0
    v_mov_b32 v82, 0
    v_mov_b32 v83, 0
    v_mov_b32 v84, 0
    v_mov_b32 v85, 0
    v_mov_b32 v86, 0
    v_mov_b32 v87, 0
    v_mov_b32 v88, 0
    v_mov_b32 v89, 0
    v_mov_b32 v90, 0
    v_mov_b32 v91, 0
    v_mov_b32 v92, 0
    v_mov_b32 v93, 0
    v_mov_b32 v94, 0
    v_mov_b32 v95, 0
    v_mov_b32 v96, 0
    v_mov_b32 v97, 0
    v_mov_b32 v98, 0
    v_mov_b32 v99, 0
    v_mov_b32 v100, 0
    v_mov_b32 v101, 0
    v_mov_b32 v102, 0
    v_mov_b32 v103, 0
K2_NOINIT:
    v_mov_b32 v138, 1
    v_lshlrev_b32 v146, 2, v1
    s_waitcnt vmcnt(0)
    v_bfe_u32 v158, v202, 14, 6
    v_lshlrev_b32 v158, 2, v158
    v_bfe_u32 v159, v206, 14, 6
    v_lshlrev_b32 v159, 2, v159
    v_lshrrev_b32 v8, 1, v1
    v_lshlrev_b32 v8, 2, v8
    v_add_u32 v9, 128, v8
    ds_bpermute_b32 v224, v8, v203
    ds_bpermute_b32 v225, v9, v203
    ds_bpermute_b32 v226, v8, v207
    ds_bpermute_b32 v227, v9, v207
    v_and_b32 v9, 1, v1
    v_lshlrev_b32 v9, 4, v9
    v_mov_b32 v4, 0x7ffffff0
    s_waitcnt lgkmcnt(0)
    v_lshl_add_u32 v224, v224, 5, v9
    v_cndmask_b32 v224, v4, v224, s[42:43]
    v_lshl_add_u32 v225, v225, 5, v9
    v_cndmask_b32 v225, v4, v225, s[44:45]
    v_lshl_add_u32 v226, v226, 5, v9
    v_cndmask_b32 v226, v4, v226, s[46:47]
    v_lshl_add_u32 v227, v227, 5, v9
    v_cndmask_b32 v227, v4, v227, s[36:37]
    buffer_load_dwordx4 v[208:211], v224, s[76:79], 0 offen
    buffer_load_dwordx4 v[212:215], v225, s[76:79], 0 offen
    buffer_load_dwordx4 v[216:219], v226, s[76:79], 0 offen
    buffer_load_dwordx4 v[220:223], v227, s[76:79], 0 offen
    s_cmp_eq_u32 s20, 0
    s_cbranch_scc0 K2_OWNED
    s_mov_b64 exec, s[38:39]
    s_cbranch_execz K2_D0
    ds_add_u32 v158, v138 offset:2304
K2_D0:
    s_mov_b64 exec, s[40:41]
    s_cbranch_execz K2_D1
    ds_add_u32 v159, v138 offset:2304
K2_D1:
    s_mov_b64 exec, -1
    v_sub_u32 v148, 63, v1
    s_mul_i32 s27, s4, 5
    v_mov_b32 v149, 0
    s_waitcnt lgkmcnt(0)
    s_barrier
    ds_read_b32 v147, v146 offset:2304
    v_and_b32 v140, 0x3fff, v202
    v_and_b32 v141, 0x3fff, v206
    s_waitcnt lgkmcnt(0)
    v_lshl_add_u32 v147, v147, 6, v148
    s_nop 0
    v_readlane_b32 s68, v147, s27
    s_add_u32 s27, s27, 1
    v_readlane_b32 s69, v147, s27
    s_add_u32 s27, s27, 1
    v_readlane_b32 s70, v147, s27
    s_add_u32 s27, s27, 1
    v_readlane_b32 s71, v147, s27
    s_add_u32 s27, s27, 1
    v_readlane_b32 s72, v147, s27
    s_add_u32 s27, s27, 1
    s_nop 0
    v_cmp_gt_u32 vcc, s68, v147
    s_nop 1
    v_addc_co_u32 v149, vcc, 0, v149, vcc
    v_cmp_gt_u32 vcc, s69, v147
    s_nop 1
    v_addc_co_u32 v149, vcc, 0, v149, vcc
    v_cmp_gt_u32 vcc, s70, v147
    s_nop 1
    v_addc_co_u32 v149, vcc, 0, v149, vcc
    v_cmp_gt_u32 vcc, s71, v147
    s_nop 1
    v_addc_co_u32 v149, vcc, 0, v149, vcc
    v_cmp_gt_u32 vcc, s72, v147
    s_nop 1
    v_addc_co_u32 v149, vcc, 0, v149, vcc
    ds_add_u32 v146, v149 offset:2560
    s_waitcnt lgkmcnt(0)
    s_barrier
    ds_read_b32 v147, v146 offset:2560
    s_waitcnt lgkmcnt(0)
    v_lshlrev_b32 v147, 2, v147
    ds_bpermute_b32 v51, v147, v50
    s_waitcnt lgkmcnt(0)
K2_OWNED:
    ds_bpermute_b32 v160, v158, v51
    ds_bpermute_b32 v161, v159, v51
    v_and_b32 v140, 0x3fff, v202
    v_mul_u32_u24 v146, 838, v140
    v_lshlrev_b32 v142, 10, v140
    v_lshrrev_b32 v146, 18, v146
    v_and_b32 v141, 0x3fff, v206
    v_mul_u32_u24 v147, 838, v141
    v_lshlrev_b32 v143, 10, v141
    v_lshrrev_b32 v147, 18, v147
    s_waitcnt lgkmcnt(0)
    v_and_b32 v4, 7, v160
    v_lshl_add_u32 v146, v4, 5, v146
    v_lshlrev_b32 v140, 2, v146
    v_and_b32 v4, 0x38, v160
    v_or_b32 v142, v142, v4
    v_and_b32 v4, 7, v161
    v_lshl_add_u32 v147, v4, 5, v147
    v_lshlrev_b32 v141, 2, v147
    v_and_b32 v4, 0x38, v161
    v_or_b32 v143, v143, v4
    s_mov_b64 exec, s[38:39]
    s_cbranch_execz K2_H0
    ds_add_rtn_u32 v144, v140, v138 offset:0
K2_H0:
    s_mov_b64 exec, s[40:41]
    s_cbranch_execz K2_H1
    ds_add_rtn_u32 v145, v141, v138 offset:0
K2_H1:
    s_mov_b64 exec, -1
    s_add_u32 s27, s4, 0
    v_cmp_eq_u32 vcc, s27, v51
    s_ff1_i32_b64 s68, vcc
    s_mul_i32 s68, s68, 1088
    s_add_u32 s27, s4, 8
    v_cmp_eq_u32 vcc, s27, v51
    s_ff1_i32_b64 s69, vcc
    s_mul_i32 s69, s69, 1088
    s_add_u32 s27, s4, 16
    v_cmp_eq_u32 vcc, s27, v51
    s_ff1_i32_b64 s70, vcc
    s_mul_i32 s70, s70, 1088
    s_add_u32 s27, s4, 24
    v_cmp_eq_u32 vcc, s27, v51
    s_ff1_i32_b64 s71, vcc
    s_mul_i32 s71, s71, 1088
    s_add_u32 s27, s4, 32
    v_cmp_eq_u32 vcc, s27, v51
    s_ff1_i32_b64 s72, vcc
    s_mul_i32 s72, s72, 1088
    v_mov_b32 v4, 2048
    s_waitcnt lgkmcnt(0)
    s_barrier
    ds_read_b32 v9, v4
    ds_read_b128 v[148:151], v2 offset:0
    s_waitcnt lgkmcnt(0)
    v_add_u32 v154, v148, v149
    v_add_u32 v155, v154, v150
    v_add_u32 v156, v155, v151
    v_mov_b32 v152, v156
    s_nop 1
    v_add_u32_dpp v156, v156, v156 row_shr:1 row_mask:0xf bank_mask:0xf
    s_nop 1
    v_add_u32_dpp v156, v156, v156 row_shr:2 row_mask:0xf bank_mask:0xf
    s_nop 1
    v_add_u32_dpp v156, v156, v156 row_shr:4 row_mask:0xf bank_mask:0xf
    s_nop 1
    v_add_u32_dpp v156, v156, v156 row_shr:8 row_mask:0xf bank_mask:0xf
    s_nop 1
    v_add_u32_dpp v156, v156, v156 row_bcast:15 row_mask:0xa bank_mask:0xf
    s_nop 1
    v_add_u32_dpp v156, v156, v156 row_bcast:31 row_mask:0xc bank_mask:0xf
    s_nop 0
    v_sub_u32 v152, v156, v152
    v_add_u32 v153, v152, v148
    v_add_u32 v154, v152, v154
    v_add_u32 v155, v152, v155
    ds_write_b128 v2, v[152:155] offset:1024
    v_readfirstlane_b32 s21, v9
    s_lshl_b32 s27, s4, 3
    v_readlane_b32 s22, v152, s27
    s_add_u32 s27, s27, 8
    s_min_u32 s27, s27, 63
    v_readlane_b32 s28, v152, s27
    v_readlane_b32 s29, v156, 63
    v_readlane_b32 s66, v156, 63
    s_waitcnt lgkmcnt(0)
    ds_read_b32 v146, v140 offset:1024
    ds_read_b32 v147, v141 offset:1024
    s_cmp_eq_u32 s4, 7
    s_cselect_b32 s28, s29, s28
    s_sub_u32 s23, s28, s22
    s_waitcnt lgkmcnt(0)
    v_add_u32 v144, v144, v146
    v_lshlrev_b32 v146, 2, v144
    v_add_u32 v145, v145, v147
    v_lshlrev_b32 v147, 2, v145
    s_mov_b64 exec, s[38:39]
    s_cbranch_execz K2_S0
    ds_write_b32 v146, v142 offset:8192
K2_S0:
    s_mov_b64 exec, s[40:41]
    s_cbranch_execz K2_S1
    ds_write_b32 v147, v143 offset:8192
K2_S1:
    s_mov_b64 exec, -1
    v_lshrrev_b32 v8, 1, v1
    v_lshlrev_b32 v8, 2, v8
    v_add_u32 v9, 128, v8
    ds_bpermute_b32 v160, v8, v144
    ds_bpermute_b32 v161, v9, v144
    ds_bpermute_b32 v162, v8, v145
    ds_bpermute_b32 v163, v9, v145
    v_add_u32 v12, s22, v3
    v_lshlrev_b32 v12, 2, v12
    v_cmp_gt_i32 vcc, s23, v3
    s_waitcnt lgkmcnt(0)
    s_barrier
    ds_read_b32 v17, v12 offset:8192
    v_mov_b32 v4, 0
    v_lshlrev_b32 v8, 2, v0
    s_cmp_lt_u32 s4, 4
    s_cbranch_scc0 K2_Z2
    ds_write_b32 v8, v4 offset:0
K2_Z2:
    s_waitcnt lgkmcnt(0)
    v_cndmask_b32 v17, 0, v17, vcc
    s_nop 0
    v_readlane_b32 s48, v17, 0
    v_readlane_b32 s49, v17, 1
    v_readlane_b32 s50, v17, 2
    v_readlane_b32 s51, v17, 3
    v_readlane_b32 s52, v17, 4
    v_readlane_b32 s53, v17, 5
    s_nop 3
    s_and_b32 s25, s48, 0xfffffc00
    buffer_load_dwordx4 v[104:107], v2, s[8:11], s25 offen
    s_and_b32 s25, s49, 0xfffffc00
    buffer_load_dwordx4 v[108:111], v2, s[8:11], s25 offen
    s_and_b32 s25, s50, 0xfffffc00
    buffer_load_dwordx4 v[112:115], v2, s[8:11], s25 offen
    s_and_b32 s25, s51, 0xfffffc00
    buffer_load_dwordx4 v[116:119], v2, s[8:11], s25 offen
    v_and_b32 v9, 1, v1
    v_lshlrev_b32 v9, 4, v9
    v_lshl_add_u32 v224, v160, 5, v9
    v_lshl_add_u32 v225, v161, 5, v9
    v_lshl_add_u32 v226, v162, 5, v9
    v_lshl_add_u32 v227, v163, 5, v9
    s_waitcnt vmcnt(4)
    s_mov_b64 exec, s[38:39]
    s_cbranch_execz K2_T0
    v_lshlrev_b32 v8, 3, v144
    ds_write_b64 v8, v[200:201] offset:12800
K2_T0:
    s_mov_b64 exec, s[40:41]
    s_cbranch_execz K2_T1
    v_lshlrev_b32 v8, 3, v145
    ds_write_b64 v8, v[204:205] offset:12800
K2_T1:
    s_mov_b64 exec, s[42:43]
    s_cbranch_execz K2_U0
    ds_write_b128 v224, v[208:211] offset:21248
K2_U0:
    s_mov_b64 exec, s[44:45]
    s_cbranch_execz K2_U1
    ds_write_b128 v225, v[212:215] offset:21248
K2_U1:
    s_mov_b64 exec, s[46:47]
    s_cbranch_execz K2_U2
    ds_write_b128 v226, v[216:219] offset:21248
K2_U2:
    s_mov_b64 exec, s[36:37]
    s_cbranch_execz K2_U3
    ds_write_b128 v227, v[220:223] offset:21248
K2_U3:
    s_mov_b64 exec, -1
    v_add_u32 v4, 98560, v2
    ds_read_b128 v[168:171], v4 offset:0
    ds_read_b128 v[172:175], v4 offset:1024
    ds_read_b128 v[176:179], v4 offset:2048
    ds_read_b128 v[180:183], v4 offset:3072
    v_and_b32 v8, 3, v1
    v_lshlrev_b32 v8, 5, v8
    v_add_u32 v8, 102656, v8
    ds_read_b128 v[184:187], v8 offset:0
    ds_read_b128 v[188:191], v8 offset:16
    v_lshrrev_b32 v4, 2, v1
    v_add_u32 v13, s22, v4
    v_lshlrev_b32 v13, 3, v13
    v_bfe_u32 v4, v1, 3, 2
    v_and_b32 v8, 3, v1
    v_lshl_add_u32 v4, v4, 2, v8
    v_add_u32 v4, s22, v4
    v_lshlrev_b32 v4, 5, v4
    v_lshrrev_b32 v8, 5, v1
    v_lshl_add_u32 v14, v8, 4, v4
    v_add_u32 v14, 21248, v14
    v_mov_b32 v4, 2064
    v_cndmask_b32 v15, v4, v14, s[30:31]
    v_cndmask_b32 v16, v4, v14, s[32:33]
    v_mov_b32 v128, 0
    v_mov_b32 v129, 0
    v_mov_b32 v130, 0
    v_mov_b32 v131, 0
    v_mov_b32 v132, 0
    v_mov_b32 v133, 0
    v_mov_b32 v134, 0
    v_mov_b32 v135, 0
    v_mov_b32 v46, 0
    v_mov_b32 v47, 0
    v_mov_b32 v48, 0
    v_mov_b32 v49, 0
    s_mov_b32 s63, 0
    s_mov_b32 s24, s23
    s_sub_i32 s26, s23, 16
    s_waitcnt lgkmcnt(0)
    s_and_b32 s25, s52, 0xfffffc00
    s_barrier
    ds_read_b128 v[52:55], v15
    ds_read_b128 v[56:59], v16
    ds_read_b64 v[24:25], v13 offset:12800
    s_waitcnt lgkmcnt(1)
    v_mfma_f32_32x32x16_bf16 v[136:151], v[52:55], v[168:171], 0
    v_mfma_f32_32x32x16_bf16 v[136:151], v[56:59], v[172:175], v[136:151]
    v_mfma_f32_32x32x16_bf16 v[152:167], v[52:55], v[176:179], 0
    v_mfma_f32_32x32x16_bf16 v[152:167], v[56:59], v[180:183], v[152:167]
    s_waitcnt lgkmcnt(0)
    v_mfma_f32_4x4x4_16b_bf16 v[192:195], v[24:25], v[184:185], 0
    v_mfma_f32_4x4x4_16b_bf16 v[196:199], v[24:25], v[186:187], 0
    v_mfma_f32_4x4x4_16b_bf16 v[28:31], v[24:25], v[188:189], 0
    v_mfma_f32_4x4x4_16b_bf16 v[8:11], v[24:25], v[190:191], 0
    s_nop 4
    v_cvt_pk_bf16_f32 v20, v192, v196
    v_cvt_pk_bf16_f32 v21, v28, v8
    s_nop 3
    s_nop 7
    v_pk_mul_f32 v[38:39], v[136:137], s[34:35]
    v_pk_mul_f32 v[40:41], v[152:153], s[34:35]
    v_exp_f32 v38, v38
    v_exp_f32 v39, v39
    v_exp_f32 v40, v40
    v_exp_f32 v41, v41
    s_nop 0
    v_pk_add_f32 v[38:39], v[38:39], 1.0 op_sel_hi:[1,0]
    v_pk_add_f32 v[40:41], v[40:41], 1.0 op_sel_hi:[1,0]
    v_rcp_f32 v38, v38
    v_rcp_f32 v39, v39
    v_rcp_f32 v40, v40
    v_rcp_f32 v41, v41
    s_nop 0
    v_pk_mul_f32 v[42:43], v[136:137], v[38:39]
    v_pk_mul_f32 v[44:45], v[152:153], v[40:41]
    v_pk_mul_f32 v[38:39], v[138:139], s[34:35]
    v_pk_mul_f32 v[40:41], v[154:155], s[34:35]
    s_lshl_b32 s27, s4, 2
    s_add_u32 s28, s27, 2816
    v_mov_b32 v60, s28
    s_xor_b32 s27, s27, 16
    s_add_u32 s28, s27, 2816
    v_mov_b32 v61, s28
    s_branch K2_LOOP
.p2align 12
K2_LOOP:
    ds_read_b32 v18, v12 offset:8256
    ds_read_b64 v[24:25], v13 offset:12928
    v_mov_b32 v4, s24
    ds_write_b32 v60, v4
    ds_read_b32 v62, v61
    s_waitcnt vmcnt(3)
    v_mfma_f32_4x4x4_16b_bf16 v[120:123], v[20:21], v[104:105], 0 cbsz:4 abid:0
    v_mfma_f32_4x4x4_16b_bf16 v[124:127], v[20:21], v[106:107], 0 cbsz:4 abid:0
    buffer_load_dwordx4 v[104:107], v2, s[8:11], s25 offen
    v_exp_f32 v38, v38
    s_and_b32 s25, s53, 0xfffffc00
    v_exp_f32 v39, v39
    s_sub_u32 s24, s24, 1
    v_exp_f32 v40, v40
    v_exp_f32 v41, v41
    v_readlane_b32 s54, v17, 6
    s_set_gpr_idx_on s63, gpr_idx(SRC2,DST)
    v_pk_fma_f32 v[64:65], v[46:47], v[128:129], v[64:65] op_sel:[1,0,0] op_sel_hi:[1,1,1]
    v_pk_fma_f32 v[66:67], v[46:47], v[130:131], v[66:67] op_sel:[1,0,0] op_sel_hi:[1,1,1]
    v_pk_fma_f32 v[68:69], v[48:49], v[132:133], v[68:69] op_sel:[1,0,0] op_sel_hi:[1,1,1]
    v_pk_fma_f32 v[70:71], v[48:49], v[134:135], v[70:71] op_sel:[1,0,0] op_sel_hi:[1,1,1]
    s_set_gpr_idx_off
    s_cbranch_scc1 K2_EXIT
    v_pk_add_f32 v[38:39], v[38:39], 1.0 op_sel_hi:[1,0]
    v_pk_add_f32 v[40:41], v[40:41], 1.0 op_sel_hi:[1,0]
    s_waitcnt vmcnt(3)
    v_mfma_f32_4x4x4_16b_bf16 v[128:131], v[20:21], v[108:109], 0 cbsz:4 abid:1
    v_mfma_f32_4x4x4_16b_bf16 v[132:135], v[20:21], v[110:111], 0 cbsz:4 abid:1
    buffer_load_dwordx4 v[108:111], v2, s[8:11], s25 offen
    v_rcp_f32 v38, v38
    s_and_b32 s25, s54, 0xfffffc00
    v_rcp_f32 v39, v39
    s_sub_u32 s24, s24, 1
    v_rcp_f32 v40, v40
    v_rcp_f32 v41, v41
    v_readlane_b32 s55, v17, 7
    s_set_gpr_idx_on s48, gpr_idx(SRC2,DST)
    v_pk_fma_f32 v[64:65], v[42:43], v[120:121], v[64:65] op_sel:[0,0,0] op_sel_hi:[0,1,1]
    v_pk_fma_f32 v[66:67], v[42:43], v[122:123], v[66:67] op_sel:[0,0,0] op_sel_hi:[0,1,1]
    v_pk_fma_f32 v[68:69], v[44:45], v[124:125], v[68:69] op_sel:[0,0,0] op_sel_hi:[0,1,1]
    v_pk_fma_f32 v[70:71], v[44:45], v[126:127], v[70:71] op_sel:[0,0,0] op_sel_hi:[0,1,1]
    s_set_gpr_idx_off
    s_cbranch_scc1 K2_EXIT
    v_pk_mul_f32 v[46:47], v[138:139], v[38:39]
    v_pk_mul_f32 v[48:49], v[154:155], v[40:41]
    v_pk_mul_f32 v[38:39], v[140:141], s[34:35]
    v_pk_mul_f32 v[40:41], v[156:157], s[34:35]
    v_add_u32 v14, 512, v14
    v_mov_b32 v4, 2064
    v_cndmask_b32 v15, v4, v14, s[30:31]
    v_cndmask_b32 v16, v4, v14, s[32:33]
    ds_read_b128 v[52:55], v15
    ds_read_b128 v[56:59], v16
    s_waitcnt vmcnt(3)
    v_mfma_f32_4x4x4_16b_bf16 v[120:123], v[20:21], v[112:113], 0 cbsz:4 abid:2
    v_mfma_f32_4x4x4_16b_bf16 v[124:127], v[20:21], v[114:115], 0 cbsz:4 abid:2
    buffer_load_dwordx4 v[112:115], v2, s[8:11], s25 offen
    v_exp_f32 v38, v38
    s_and_b32 s25, s55, 0xfffffc00
    v_exp_f32 v39, v39
    s_sub_u32 s24, s24, 1
    v_exp_f32 v40, v40
    v_exp_f32 v41, v41
    v_readlane_b32 s56, v17, 8
    s_set_gpr_idx_on s49, gpr_idx(SRC2,DST)
    v_pk_fma_f32 v[64:65], v[42:43], v[128:129], v[64:65] op_sel:[1,0,0] op_sel_hi:[1,1,1]
    v_pk_fma_f32 v[66:67], v[42:43], v[130:131], v[66:67] op_sel:[1,0,0] op_sel_hi:[1,1,1]
    v_pk_fma_f32 v[68:69], v[44:45], v[132:133], v[68:69] op_sel:[1,0,0] op_sel_hi:[1,1,1]
    v_pk_fma_f32 v[70:71], v[44:45], v[134:135], v[70:71] op_sel:[1,0,0] op_sel_hi:[1,1,1]
    s_set_gpr_idx_off
    s_cbranch_scc1 K2_EXIT
    v_pk_add_f32 v[38:39], v[38:39], 1.0 op_sel_hi:[1,0]
    v_pk_add_f32 v[40:41], v[40:41], 1.0 op_sel_hi:[1,0]
    s_waitcnt vmcnt(3)
    v_mfma_f32_4x4x4_16b_bf16 v[128:131], v[20:21], v[116:117], 0 cbsz:4 abid:3
    v_mfma_f32_4x4x4_16b_bf16 v[132:135], v[20:21], v[118:119], 0 cbsz:4 abid:3
    buffer_load_dwordx4 v[116:119], v2, s[8:11], s25 offen
    v_rcp_f32 v38, v38
    s_and_b32 s25, s56, 0xfffffc00
    v_rcp_f32 v39, v39
    s_sub_u32 s24, s24, 1
    v_rcp_f32 v40, v40
    v_rcp_f32 v41, v41
    v_readlane_b32 s57, v17, 9
    s_set_gpr_idx_on s50, gpr_idx(SRC2,DST)
    v_pk_fma_f32 v[64:65], v[46:47], v[120:121], v[64:65] op_sel:[0,0,0] op_sel_hi:[0,1,1]
    v_pk_fma_f32 v[66:67], v[46:47], v[122:123], v[66:67] op_sel:[0,0,0] op_sel_hi:[0,1,1]
    v_pk_fma_f32 v[68:69], v[48:49], v[124:125], v[68:69] op_sel:[0,0,0] op_sel_hi:[0,1,1]
    v_pk_fma_f32 v[70:71], v[48:49], v[126:127], v[70:71] op_sel:[0,0,0] op_sel_hi:[0,1,1]
    s_set_gpr_idx_off
    s_cbranch_scc1 K2_EXIT
    v_pk_mul_f32 v[42:43], v[140:141], v[38:39]
    v_pk_mul_f32 v[44:45], v[156:157], v[40:41]
    v_pk_mul_f32 v[38:39], v[142:143], s[34:35]
    v_pk_mul_f32 v[40:41], v[158:159], s[34:35]
    s_waitcnt lgkmcnt(0)
    v_cmp_gt_i32 vcc, s26, v3
    s_nop 0
    s_nop 0
    v_cndmask_b32 v18, 0, v18, vcc
    v_readfirstlane_b32 s27, v62
    s_add_u32 s28, s24, 11
    s_cmp_gt_u32 s28, s27
    s_cbranch_scc1 K2_PHI
    s_setprio 0
    s_branch K2_PDN
K2_PHI:
    s_setprio 1
K2_PDN:
    s_waitcnt vmcnt(3)
    v_mfma_f32_4x4x4_16b_bf16 v[120:123], v[20:21], v[104:105], 0 cbsz:4 abid:4
    v_mfma_f32_4x4x4_16b_bf16 v[124:127], v[20:21], v[106:107], 0 cbsz:4 abid:4
    buffer_load_dwordx4 v[104:107], v2, s[8:11], s25 offen
    v_mfma_f32_4x4x4_16b_bf16 v[192:195], v[24:25], v[184:185], 0
    v_mfma_f32_4x4x4_16b_bf16 v[196:199], v[24:25], v[186:187], 0
    v_exp_f32 v38, v38
    s_and_b32 s25, s57, 0xfffffc00
    v_exp_f32 v39, v39
    s_sub_u32 s24, s24, 1
    v_exp_f32 v40, v40
    v_exp_f32 v41, v41
    v_readlane_b32 s58, v17, 10
    s_set_gpr_idx_on s51, gpr_idx(SRC2,DST)
    v_pk_fma_f32 v[64:65], v[46:47], v[128:129], v[64:65] op_sel:[1,0,0] op_sel_hi:[1,1,1]
    v_pk_fma_f32 v[66:67], v[46:47], v[130:131], v[66:67] op_sel:[1,0,0] op_sel_hi:[1,1,1]
    v_pk_fma_f32 v[68:69], v[48:49], v[132:133], v[68:69] op_sel:[1,0,0] op_sel_hi:[1,1,1]
    v_pk_fma_f32 v[70:71], v[48:49], v[134:135], v[70:71] op_sel:[1,0,0] op_sel_hi:[1,1,1]
    s_set_gpr_idx_off
    s_cbranch_scc1 K2_EXIT
    v_pk_add_f32 v[38:39], v[38:39], 1.0 op_sel_hi:[1,0]
    v_pk_add_f32 v[40:41], v[40:41], 1.0 op_sel_hi:[1,0]
    s_waitcnt vmcnt(3)
    v_mfma_f32_4x4x4_16b_bf16 v[128:131], v[20:21], v[108:109], 0 cbsz:4 abid:5
    v_mfma_f32_4x4x4_16b_bf16 v[132:135], v[20:21], v[110:111], 0 cbsz:4 abid:5
    buffer_load_dwordx4 v[108:111], v2, s[8:11], s25 offen
    v_mfma_f32_4x4x4_16b_bf16 v[28:31], v[24:25], v[188:189], 0
    v_mfma_f32_4x4x4_16b_bf16 v[8:11], v[24:25], v[190:191], 0
    v_rcp_f32 v38, v38
    s_and_b32 s25, s58, 0xfffffc00
    v_rcp_f32 v39, v39
    s_sub_u32 s24, s24, 1
    v_rcp_f32 v40, v40
    v_rcp_f32 v41, v41
    v_readlane_b32 s59, v17, 11
    s_set_gpr_idx_on s52, gpr_idx(SRC2,DST)
    v_pk_fma_f32 v[64:65], v[42:43], v[120:121], v[64:65] op_sel:[0,0,0] op_sel_hi:[0,1,1]
    v_pk_fma_f32 v[66:67], v[42:43], v[122:123], v[66:67] op_sel:[0,0,0] op_sel_hi:[0,1,1]
    v_pk_fma_f32 v[68:69], v[44:45], v[124:125], v[68:69] op_sel:[0,0,0] op_sel_hi:[0,1,1]
    v_pk_fma_f32 v[70:71], v[44:45], v[126:127], v[70:71] op_sel:[0,0,0] op_sel_hi:[0,1,1]
    s_set_gpr_idx_off
    s_cbranch_scc1 K2_EXIT
    v_pk_mul_f32 v[46:47], v[142:143], v[38:39]
    v_pk_mul_f32 v[48:49], v[158:159], v[40:41]
    v_pk_mul_f32 v[38:39], v[144:145], s[34:35]
    v_pk_mul_f32 v[40:41], v[160:161], s[34:35]
    s_waitcnt vmcnt(3)
    v_mfma_f32_4x4x4_16b_bf16 v[120:123], v[20:21], v[112:113], 0 cbsz:4 abid:6
    v_mfma_f32_4x4x4_16b_bf16 v[124:127], v[20:21], v[114:115], 0 cbsz:4 abid:6
    buffer_load_dwordx4 v[112:115], v2, s[8:11], s25 offen
    v_exp_f32 v38, v38
    s_and_b32 s25, s59, 0xfffffc00
    v_exp_f32 v39, v39
    s_sub_u32 s24, s24, 1
    v_exp_f32 v40, v40
    v_exp_f32 v41, v41
    v_readlane_b32 s60, v17, 12
    s_set_gpr_idx_on s53, gpr_idx(SRC2,DST)
    v_pk_fma_f32 v[64:65], v[42:43], v[128:129], v[64:65] op_sel:[1,0,0] op_sel_hi:[1,1,1]
    v_pk_fma_f32 v[66:67], v[42:43], v[130:131], v[66:67] op_sel:[1,0,0] op_sel_hi:[1,1,1]
    v_pk_fma_f32 v[68:69], v[44:45], v[132:133], v[68:69] op_sel:[1,0,0] op_sel_hi:[1,1,1]
    v_pk_fma_f32 v[70:71], v[44:45], v[134:135], v[70:71] op_sel:[1,0,0] op_sel_hi:[1,1,1]
    s_set_gpr_idx_off
    s_cbranch_scc1 K2_EXIT
    v_pk_add_f32 v[38:39], v[38:39], 1.0 op_sel_hi:[1,0]
    v_pk_add_f32 v[40:41], v[40:41], 1.0 op_sel_hi:[1,0]
    v_cvt_pk_bf16_f32 v22, v192, v196
    v_cvt_pk_bf16_f32 v23, v28, v8
    s_waitcnt vmcnt(3)
    v_mfma_f32_4x4x4_16b_bf16 v[128:131], v[20:21], v[116:117], 0 cbsz:4 abid:7
    v_mfma_f32_4x4x4_16b_bf16 v[132:135], v[20:21], v[118:119], 0 cbsz:4 abid:7
    buffer_load_dwordx4 v[116:119], v2, s[8:11], s25 offen
    v_rcp_f32 v38, v38
    s_and_b32 s25, s60, 0xfffffc00
    v_rcp_f32 v39, v39
    s_sub_u32 s24, s24, 1
    v_rcp_f32 v40, v40
    v_rcp_f32 v41, v41
    v_readlane_b32 s61, v17, 13
    s_set_gpr_idx_on s54, gpr_idx(SRC2,DST)
    v_pk_fma_f32 v[64:65], v[46:47], v[120:121], v[64:65] op_sel:[0,0,0] op_sel_hi:[0,1,1]
    v_pk_fma_f32 v[66:67], v[46:47], v[122:123], v[66:67] op_sel:[0,0,0] op_sel_hi:[0,1,1]
    v_pk_fma_f32 v[68:69], v[48:49], v[124:125], v[68:69] op_sel:[0,0,0] op_sel_hi:[0,1,1]
    v_pk_fma_f32 v[70:71], v[48:49], v[126:127], v[70:71] op_sel:[0,0,0] op_sel_hi:[0,1,1]
    s_set_gpr_idx_off
    s_cbranch_scc1 K2_EXIT
    v_pk_mul_f32 v[42:43], v[144:145], v[38:39]
    v_pk_mul_f32 v[44:45], v[160:161], v[40:41]
    v_pk_mul_f32 v[38:39], v[146:147], s[34:35]
    v_pk_mul_f32 v[40:41], v[162:163], s[34:35]
    s_waitcnt vmcnt(3)
    v_mfma_f32_4x4x4_16b_bf16 v[120:123], v[20:21], v[104:105], 0 cbsz:4 abid:8
    v_mfma_f32_4x4x4_16b_bf16 v[124:127], v[20:21], v[106:107], 0 cbsz:4 abid:8
    buffer_load_dwordx4 v[104:107], v2, s[8:11], s25 offen
    v_exp_f32 v38, v38
    s_and_b32 s25, s61, 0xfffffc00
    v_exp_f32 v39, v39
    s_sub_u32 s24, s24, 1
    v_exp_f32 v40, v40
    v_exp_f32 v41, v41
    v_readlane_b32 s62, v17, 14
    s_set_gpr_idx_on s55, gpr_idx(SRC2,DST)
    v_pk_fma_f32 v[64:65], v[46:47], v[128:129], v[64:65] op_sel:[1,0,0] op_sel_hi:[1,1,1]
    v_pk_fma_f32 v[66:67], v[46:47], v[130:131], v[66:67] op_sel:[1,0,0] op_sel_hi:[1,1,1]
    v_pk_fma_f32 v[68:69], v[48:49], v[132:133], v[68:69] op_sel:[1,0,0] op_sel_hi:[1,1,1]
    v_pk_fma_f32 v[70:71], v[48:49], v[134:135], v[70:71] op_sel:[1,0,0] op_sel_hi:[1,1,1]
    s_set_gpr_idx_off
    s_cbranch_scc1 K2_EXIT
    v_pk_add_f32 v[38:39], v[38:39], 1.0 op_sel_hi:[1,0]
    v_pk_add_f32 v[40:41], v[40:41], 1.0 op_sel_hi:[1,0]
    v_mov_b32 v34, v148
    v_mov_b32 v35, v149
    v_mov_b32 v36, v150
    v_mov_b32 v37, v151
    v_mov_b32 v10, v166
    v_mov_b32 v11, v167
    s_waitcnt vmcnt(3)
    v_mfma_f32_4x4x4_16b_bf16 v[128:131], v[20:21], v[108:109], 0 cbsz:4 abid:9
    v_mfma_f32_4x4x4_16b_bf16 v[132:135], v[20:21], v[110:111], 0 cbsz:4 abid:9
    buffer_load_dwordx4 v[108:111], v2, s[8:11], s25 offen
    v_rcp_f32 v38, v38
    s_and_b32 s25, s62, 0xfffffc00
    v_rcp_f32 v39, v39
    s_sub_u32 s24, s24, 1
    v_rcp_f32 v40, v40
    v_rcp_f32 v41, v41
    v_readlane_b32 s63, v17, 15
    s_set_gpr_idx_on s56, gpr_idx(SRC2,DST)
    v_pk_fma_f32 v[64:65], v[42:43], v[120:121], v[64:65] op_sel:[0,0,0] op_sel_hi:[0,1,1]
    v_pk_fma_f32 v[66:67], v[42:43], v[122:123], v[66:67] op_sel:[0,0,0] op_sel_hi:[0,1,1]
    v_pk_fma_f32 v[68:69], v[44:45], v[124:125], v[68:69] op_sel:[0,0,0] op_sel_hi:[0,1,1]
    v_pk_fma_f32 v[70:71], v[44:45], v[126:127], v[70:71] op_sel:[0,0,0] op_sel_hi:[0,1,1]
    s_set_gpr_idx_off
    s_cbranch_scc1 K2_EXIT
    v_pk_mul_f32 v[46:47], v[146:147], v[38:39]
    v_pk_mul_f32 v[48:49], v[162:163], v[40:41]
    v_pk_mul_f32 v[38:39], v[34:35], s[34:35]
    v_pk_mul_f32 v[40:41], v[164:165], s[34:35]
    s_waitcnt vmcnt(3)
    v_mfma_f32_4x4x4_16b_bf16 v[120:123], v[20:21], v[112:113], 0 cbsz:4 abid:10
    v_mfma_f32_4x4x4_16b_bf16 v[124:127], v[20:21], v[114:115], 0 cbsz:4 abid:10
    buffer_load_dwordx4 v[112:115], v2, s[8:11], s25 offen
    v_mfma_f32_32x32x16_bf16 v[136:151], v[52:55], v[168:171], 0
    v_exp_f32 v38, v38
    s_and_b32 s25, s63, 0xfffffc00
    v_exp_f32 v39, v39
    s_sub_u32 s24, s24, 1
    v_exp_f32 v40, v40
    v_exp_f32 v41, v41
    v_readlane_b32 s48, v18, 0
    s_set_gpr_idx_on s57, gpr_idx(SRC2,DST)
    v_pk_fma_f32 v[64:65], v[42:43], v[128:129], v[64:65] op_sel:[1,0,0] op_sel_hi:[1,1,1]
    v_pk_fma_f32 v[66:67], v[42:43], v[130:131], v[66:67] op_sel:[1,0,0] op_sel_hi:[1,1,1]
    v_pk_fma_f32 v[68:69], v[44:45], v[132:133], v[68:69] op_sel:[1,0,0] op_sel_hi:[1,1,1]
    v_pk_fma_f32 v[70:71], v[44:45], v[134:135], v[70:71] op_sel:[1,0,0] op_sel_hi:[1,1,1]
    s_set_gpr_idx_off
    s_cbranch_scc1 K2_EXIT
    v_pk_add_f32 v[38:39], v[38:39], 1.0 op_sel_hi:[1,0]
    v_pk_add_f32 v[40:41], v[40:41], 1.0 op_sel_hi:[1,0]
    s_waitcnt vmcnt(3)
    v_mfma_f32_4x4x4_16b_bf16 v[128:131], v[20:21], v[116:117], 0 cbsz:4 abid:11
    v_mfma_f32_4x4x4_16b_bf16 v[132:135], v[20:21], v[118:119], 0 cbsz:4 abid:11
    buffer_load_dwordx4 v[116:119], v2, s[8:11], s25 offen
    v_mfma_f32_32x32x16_bf16 v[136:151], v[56:59], v[172:175], v[136:151]
    v_rcp_f32 v38, v38
    s_and_b32 s25, s48, 0xfffffc00
    v_rcp_f32 v39, v39
    s_sub_u32 s24, s24, 1
    v_rcp_f32 v40, v40
    v_rcp_f32 v41, v41
    v_readlane_b32 s49, v18, 1
    s_set_gpr_idx_on s58, gpr_idx(SRC2,DST)
    v_pk_fma_f32 v[64:65], v[46:47], v[120:121], v[64:65] op_sel:[0,0,0] op_sel_hi:[0,1,1]
    v_pk_fma_f32 v[66:67], v[46:47], v[122:123], v[66:67] op_sel:[0,0,0] op_sel_hi:[0,1,1]
    v_pk_fma_f32 v[68:69], v[48:49], v[124:125], v[68:69] op_sel:[0,0,0] op_sel_hi:[0,1,1]
    v_pk_fma_f32 v[70:71], v[48:49], v[126:127], v[70:71] op_sel:[0,0,0] op_sel_hi:[0,1,1]
    s_set_gpr_idx_off
    s_cbranch_scc1 K2_EXIT
    v_pk_mul_f32 v[42:43], v[34:35], v[38:39]
    v_pk_mul_f32 v[44:45], v[164:165], v[40:41]
    v_pk_mul_f32 v[38:39], v[36:37], s[34:35]
    v_pk_mul_f32 v[40:41], v[10:11], s[34:35]
    s_waitcnt vmcnt(3)
    v_mfma_f32_4x4x4_16b_bf16 v[120:123], v[20:21], v[104:105], 0 cbsz:4 abid:12
    v_mfma_f32_4x4x4_16b_bf16 v[124:127], v[20:21], v[106:107], 0 cbsz:4 abid:12
    buffer_load_dwordx4 v[104:107], v2, s[8:11], s25 offen
    v_mfma_f32_32x32x16_bf16 v[152:167], v[52:55], v[176:179], 0
    v_exp_f32 v38, v38
    s_and_b32 s25, s49, 0xfffffc00
    v_exp_f32 v39, v39
    s_sub_u32 s24, s24, 1
    v_exp_f32 v40, v40
    v_exp_f32 v41, v41
    v_readlane_b32 s50, v18, 2
    s_set_gpr_idx_on s59, gpr_idx(SRC2,DST)
    v_pk_fma_f32 v[64:65], v[46:47], v[128:129], v[64:65] op_sel:[1,0,0] op_sel_hi:[1,1,1]
    v_pk_fma_f32 v[66:67], v[46:47], v[130:131], v[66:67] op_sel:[1,0,0] op_sel_hi:[1,1,1]
    v_pk_fma_f32 v[68:69], v[48:49], v[132:133], v[68:69] op_sel:[1,0,0] op_sel_hi:[1,1,1]
    v_pk_fma_f32 v[70:71], v[48:49], v[134:135], v[70:71] op_sel:[1,0,0] op_sel_hi:[1,1,1]
    s_set_gpr_idx_off
    s_cbranch_scc1 K2_EXIT
    v_pk_add_f32 v[38:39], v[38:39], 1.0 op_sel_hi:[1,0]
    v_pk_add_f32 v[40:41], v[40:41], 1.0 op_sel_hi:[1,0]
    s_waitcnt vmcnt(3)
    v_mfma_f32_4x4x4_16b_bf16 v[128:131], v[20:21], v[108:109], 0 cbsz:4 abid:13
    v_mfma_f32_4x4x4_16b_bf16 v[132:135], v[20:21], v[110:111], 0 cbsz:4 abid:13
    buffer_load_dwordx4 v[108:111], v2, s[8:11], s25 offen
    v_mfma_f32_32x32x16_bf16 v[152:167], v[56:59], v[180:183], v[152:167]
    v_rcp_f32 v38, v38
    s_and_b32 s25, s50, 0xfffffc00
    v_rcp_f32 v39, v39
    s_sub_u32 s24, s24, 1
    v_rcp_f32 v40, v40
    v_rcp_f32 v41, v41
    v_readlane_b32 s51, v18, 3
    s_set_gpr_idx_on s60, gpr_idx(SRC2,DST)
    v_pk_fma_f32 v[64:65], v[42:43], v[120:121], v[64:65] op_sel:[0,0,0] op_sel_hi:[0,1,1]
    v_pk_fma_f32 v[66:67], v[42:43], v[122:123], v[66:67] op_sel:[0,0,0] op_sel_hi:[0,1,1]
    v_pk_fma_f32 v[68:69], v[44:45], v[124:125], v[68:69] op_sel:[0,0,0] op_sel_hi:[0,1,1]
    v_pk_fma_f32 v[70:71], v[44:45], v[126:127], v[70:71] op_sel:[0,0,0] op_sel_hi:[0,1,1]
    s_set_gpr_idx_off
    s_cbranch_scc1 K2_EXIT
    v_pk_mul_f32 v[46:47], v[36:37], v[38:39]
    v_pk_mul_f32 v[48:49], v[10:11], v[40:41]
    v_pk_mul_f32 v[38:39], v[136:137], s[34:35]
    v_pk_mul_f32 v[40:41], v[152:153], s[34:35]
    s_waitcnt vmcnt(3)
    v_mfma_f32_4x4x4_16b_bf16 v[120:123], v[20:21], v[112:113], 0 cbsz:4 abid:14
    v_mfma_f32_4x4x4_16b_bf16 v[124:127], v[20:21], v[114:115], 0 cbsz:4 abid:14
    buffer_load_dwordx4 v[112:115], v2, s[8:11], s25 offen
    v_exp_f32 v38, v38
    s_and_b32 s25, s51, 0xfffffc00
    v_exp_f32 v39, v39
    s_sub_u32 s24, s24, 1
    v_exp_f32 v40, v40
    v_exp_f32 v41, v41
    v_readlane_b32 s52, v18, 4
    s_set_gpr_idx_on s61, gpr_idx(SRC2,DST)
    v_pk_fma_f32 v[64:65], v[42:43], v[128:129], v[64:65] op_sel:[1,0,0] op_sel_hi:[1,1,1]
    v_pk_fma_f32 v[66:67], v[42:43], v[130:131], v[66:67] op_sel:[1,0,0] op_sel_hi:[1,1,1]
    v_pk_fma_f32 v[68:69], v[44:45], v[132:133], v[68:69] op_sel:[1,0,0] op_sel_hi:[1,1,1]
    v_pk_fma_f32 v[70:71], v[44:45], v[134:135], v[70:71] op_sel:[1,0,0] op_sel_hi:[1,1,1]
    s_set_gpr_idx_off
    s_cbranch_scc1 K2_EXIT
    v_pk_add_f32 v[38:39], v[38:39], 1.0 op_sel_hi:[1,0]
    v_pk_add_f32 v[40:41], v[40:41], 1.0 op_sel_hi:[1,0]
    s_waitcnt vmcnt(3)
    v_mfma_f32_4x4x4_16b_bf16 v[128:131], v[20:21], v[116:117], 0 cbsz:4 abid:15
    v_mfma_f32_4x4x4_16b_bf16 v[132:135], v[20:21], v[118:119], 0 cbsz:4 abid:15
    buffer_load_dwordx4 v[116:119], v2, s[8:11], s25 offen
    v_rcp_f32 v38, v38
    s_and_b32 s25, s52, 0xfffffc00
    v_rcp_f32 v39, v39
    s_sub_u32 s24, s24, 1
    v_rcp_f32 v40, v40
    v_rcp_f32 v41, v41
    v_readlane_b32 s53, v18, 5
    s_set_gpr_idx_on s62, gpr_idx(SRC2,DST)
    v_pk_fma_f32 v[64:65], v[46:47], v[120:121], v[64:65] op_sel:[0,0,0] op_sel_hi:[0,1,1]
    v_pk_fma_f32 v[66:67], v[46:47], v[122:123], v[66:67] op_sel:[0,0,0] op_sel_hi:[0,1,1]
    v_pk_fma_f32 v[68:69], v[48:49], v[124:125], v[68:69] op_sel:[0,0,0] op_sel_hi:[0,1,1]
    v_pk_fma_f32 v[70:71], v[48:49], v[126:127], v[70:71] op_sel:[0,0,0] op_sel_hi:[0,1,1]
    s_set_gpr_idx_off
    s_cbranch_scc1 K2_EXIT
    v_pk_mul_f32 v[42:43], v[136:137], v[38:39]
    v_pk_mul_f32 v[44:45], v[152:153], v[40:41]
    v_pk_mul_f32 v[38:39], v[138:139], s[34:35]
    v_pk_mul_f32 v[40:41], v[154:155], s[34:35]
    v_mov_b32 v20, v22
    v_mov_b32 v21, v23
    v_mov_b32 v17, v18
    v_add_u32 v12, 64, v12
    v_add_u32 v13, 128, v13
    s_sub_i32 s26, s26, 16
    s_cmp_eq_u32 s65, 0
    s_cbranch_scc0 K2_LOOP
    s_add_u32 s27, s20, 1
    s_cmp_lt_u32 s27, s21
    s_cbranch_scc1 K2_LOOP
    s_mov_b32 s65, 1
    s_and_b32 s27, s4, 3
    s_lshl_b32 s27, s27, 13
    s_add_u32 s27, s27, 0x842000
    s_add_u32 s28, s27, 4096
    buffer_load_dwordx4 v[200:203], v2, s[12:15], s27 offen offset:0
    buffer_load_dwordx4 v[204:207], v2, s[12:15], s27 offen offset:1024
    buffer_load_dwordx4 v[208:211], v2, s[12:15], s27 offen offset:2048
    buffer_load_dwordx4 v[212:215], v2, s[12:15], s27 offen offset:3072
    buffer_load_dwordx4 v[216:219], v2, s[12:15], s28 offen offset:0
    buffer_load_dwordx4 v[220:223], v2, s[12:15], s28 offen offset:1024
    buffer_load_dwordx4 v[224:227], v2, s[12:15], s28 offen offset:2048
    buffer_load_dwordx4 v[228:231], v2, s[12:15], s28 offen offset:3072
    s_branch K2_LOOP
K2_EXIT:
    v_mov_b32 v4, 0
    ds_write_b32 v60, v4
    s_setprio 0
    s_waitcnt vmcnt(0) lgkmcnt(0)
    s_add_u32 s20, s20, 1
    s_cmp_lt_u32 s20, s21
    s_cbranch_scc0 K2_TAIL
    s_barrier
    s_branch K2_ROUND
K2_TAIL:
    s_cmp_eq_u32 s65, 0
    s_cbranch_scc0 K2_BMOK
    s_and_b32 s27, s4, 3
    s_lshl_b32 s27, s27, 13
    s_add_u32 s27, s27, 0x842000
    s_add_u32 s28, s27, 4096
    buffer_load_dwordx4 v[200:203], v2, s[12:15], s27 offen offset:0
    buffer_load_dwordx4 v[204:207], v2, s[12:15], s27 offen offset:1024
    buffer_load_dwordx4 v[208:211], v2, s[12:15], s27 offen offset:2048
    buffer_load_dwordx4 v[212:215], v2, s[12:15], s27 offen offset:3072
    buffer_load_dwordx4 v[216:219], v2, s[12:15], s28 offen offset:0
    buffer_load_dwordx4 v[220:223], v2, s[12:15], s28 offen offset:1024
    buffer_load_dwordx4 v[224:227], v2, s[12:15], s28 offen offset:2048
    buffer_load_dwordx4 v[228:231], v2, s[12:15], s28 offen offset:3072
K2_BMOK:
    v_lshlrev_b32 v4, 2, v1
    v_add_u32 v4, 55040, v4
    v_add_u32 v8, s68, v4
    v_cvt_pk_bf16_f32 v104, v64, v68
    ds_write_b32 v8, v104 offset:0
    v_cvt_pk_bf16_f32 v105, v65, v69
    ds_write_b32 v8, v105 offset:272
    v_cvt_pk_bf16_f32 v106, v66, v70
    ds_write_b32 v8, v106 offset:544
    v_cvt_pk_bf16_f32 v107, v67, v71
    ds_write_b32 v8, v107 offset:816
    v_add_u32 v8, s69, v4
    v_cvt_pk_bf16_f32 v108, v72, v76
    ds_write_b32 v8, v108 offset:0
    v_cvt_pk_bf16_f32 v109, v73, v77
    ds_write_b32 v8, v109 offset:272
    v_cvt_pk_bf16_f32 v110, v74, v78
    ds_write_b32 v8, v110 offset:544
    v_cvt_pk_bf16_f32 v111, v75, v79
    ds_write_b32 v8, v111 offset:816
    v_add_u32 v8, s70, v4
    v_cvt_pk_bf16_f32 v112, v80, v84
    ds_write_b32 v8, v112 offset:0
    v_cvt_pk_bf16_f32 v113, v81, v85
    ds_write_b32 v8, v113 offset:272
    v_cvt_pk_bf16_f32 v114, v82, v86
    ds_write_b32 v8, v114 offset:544
    v_cvt_pk_bf16_f32 v115, v83, v87
    ds_write_b32 v8, v115 offset:816
    v_add_u32 v8, s71, v4
    v_cvt_pk_bf16_f32 v116, v88, v92
    ds_write_b32 v8, v116 offset:0
    v_cvt_pk_bf16_f32 v117, v89, v93
    ds_write_b32 v8, v117 offset:272
    v_cvt_pk_bf16_f32 v118, v90, v94
    ds_write_b32 v8, v118 offset:544
    v_cvt_pk_bf16_f32 v119, v91, v95
    ds_write_b32 v8, v119 offset:816
    v_add_u32 v8, s72, v4
    v_cvt_pk_bf16_f32 v120, v96, v100
    ds_write_b32 v8, v120 offset:0
    v_cvt_pk_bf16_f32 v121, v97, v101
    ds_write_b32 v8, v121 offset:272
    v_cvt_pk_bf16_f32 v122, v98, v102
    ds_write_b32 v8, v122 offset:544
    v_cvt_pk_bf16_f32 v123, v99, v103
    ds_write_b32 v8, v123 offset:816
    s_waitcnt lgkmcnt(0)
    s_barrier
    v_mul_u32_u24 v4, 272, v3
    v_lshrrev_b32 v8, 4, v1
    v_lshl_add_u32 v4, v8, 4, v4
    s_lshr_b32 s27, s4, 2
    s_mul_i32 s28, s27, 21760
    s_add_u32 s28, s28, 55040
    v_add_u32 v4, s28, v4
    s_mul_i32 s28, s27, 20
    v_add_u32 v8, s28, v8
    v_lshlrev_b32 v8, 18, v8
    s_lshl_b32 s28, s5, 10
    s_and_b32 s29, s4, 3
    s_lshl_b32 s29, s29, 8
    s_add_u32 s28, s28, s29
    v_lshl_add_u32 v9, v3, 4, s28
    v_add_u32 v8, v8, v9
    ds_read_b128 v[136:139], v4 offset:0
    ds_read_b128 v[140:143], v4 offset:64
    ds_read_b128 v[144:147], v4 offset:128
    ds_read_b128 v[148:151], v4 offset:192
    s_waitcnt vmcnt(0)
    ds_read_b128 v[152:155], v4 offset:4352
    ds_read_b128 v[156:159], v4 offset:4416
    ds_read_b128 v[160:163], v4 offset:4480
    ds_read_b128 v[164:167], v4 offset:4544
    s_waitcnt lgkmcnt(4)
    v_mfma_f32_16x16x32_bf16 v[120:123], v[136:139], v[200:203], 0
    v_mfma_f32_16x16x32_bf16 v[124:127], v[136:139], v[216:219], 0
    v_mfma_f32_16x16x32_bf16 v[120:123], v[140:143], v[204:207], v[120:123]
    v_mfma_f32_16x16x32_bf16 v[124:127], v[140:143], v[220:223], v[124:127]
    v_mfma_f32_16x16x32_bf16 v[120:123], v[144:147], v[208:211], v[120:123]
    v_mfma_f32_16x16x32_bf16 v[124:127], v[144:147], v[224:227], v[124:127]
    v_mfma_f32_16x16x32_bf16 v[120:123], v[148:151], v[212:215], v[120:123]
    v_mfma_f32_16x16x32_bf16 v[124:127], v[148:151], v[228:231], v[124:127]
    ds_read_b128 v[136:139], v4 offset:8704
    ds_read_b128 v[140:143], v4 offset:8768
    ds_read_b128 v[144:147], v4 offset:8832
    ds_read_b128 v[148:151], v4 offset:8896
    s_waitcnt lgkmcnt(4)
    v_mfma_f32_16x16x32_bf16 v[128:131], v[152:155], v[200:203], 0
    v_mfma_f32_16x16x32_bf16 v[132:135], v[152:155], v[216:219], 0
    v_mfma_f32_16x16x32_bf16 v[128:131], v[156:159], v[204:207], v[128:131]
    v_mfma_f32_16x16x32_bf16 v[132:135], v[156:159], v[220:223], v[132:135]
    v_mfma_f32_16x16x32_bf16 v[128:131], v[160:163], v[208:211], v[128:131]
    v_mfma_f32_16x16x32_bf16 v[132:135], v[160:163], v[224:227], v[132:135]
    v_mfma_f32_16x16x32_bf16 v[128:131], v[164:167], v[212:215], v[128:131]
    v_mfma_f32_16x16x32_bf16 v[132:135], v[164:167], v[228:231], v[132:135]
    v_cvt_pk_bf16_f32 v104, v120, v121
    v_cvt_pk_bf16_f32 v105, v122, v123
    v_cvt_pk_bf16_f32 v106, v124, v125
    v_cvt_pk_bf16_f32 v107, v126, v127
    buffer_store_dwordx4 v[104:107], v8, s[16:19], 0 offen sc1
    v_add_u32 v8, 0x100000, v8
    ds_read_b128 v[152:155], v4 offset:13056
    ds_read_b128 v[156:159], v4 offset:13120
    ds_read_b128 v[160:163], v4 offset:13184
    ds_read_b128 v[164:167], v4 offset:13248
    s_waitcnt lgkmcnt(4)
    v_mfma_f32_16x16x32_bf16 v[120:123], v[136:139], v[200:203], 0
    v_mfma_f32_16x16x32_bf16 v[124:127], v[136:139], v[216:219], 0
    v_mfma_f32_16x16x32_bf16 v[120:123], v[140:143], v[204:207], v[120:123]
    v_mfma_f32_16x16x32_bf16 v[124:127], v[140:143], v[220:223], v[124:127]
    v_mfma_f32_16x16x32_bf16 v[120:123], v[144:147], v[208:211], v[120:123]
    v_mfma_f32_16x16x32_bf16 v[124:127], v[144:147], v[224:227], v[124:127]
    v_mfma_f32_16x16x32_bf16 v[120:123], v[148:151], v[212:215], v[120:123]
    v_mfma_f32_16x16x32_bf16 v[124:127], v[148:151], v[228:231], v[124:127]
    v_cvt_pk_bf16_f32 v108, v128, v129
    v_cvt_pk_bf16_f32 v109, v130, v131
    v_cvt_pk_bf16_f32 v110, v132, v133
    v_cvt_pk_bf16_f32 v111, v134, v135
    buffer_store_dwordx4 v[108:111], v8, s[16:19], 0 offen sc1
    v_add_u32 v8, 0x100000, v8
    ds_read_b128 v[136:139], v4 offset:17408
    ds_read_b128 v[140:143], v4 offset:17472
    ds_read_b128 v[144:147], v4 offset:17536
    ds_read_b128 v[148:151], v4 offset:17600
    s_waitcnt lgkmcnt(4)
    v_mfma_f32_16x16x32_bf16 v[128:131], v[152:155], v[200:203], 0
    v_mfma_f32_16x16x32_bf16 v[132:135], v[152:155], v[216:219], 0
    v_mfma_f32_16x16x32_bf16 v[128:131], v[156:159], v[204:207], v[128:131]
    v_mfma_f32_16x16x32_bf16 v[132:135], v[156:159], v[220:223], v[132:135]
    v_mfma_f32_16x16x32_bf16 v[128:131], v[160:163], v[208:211], v[128:131]
    v_mfma_f32_16x16x32_bf16 v[132:135], v[160:163], v[224:227], v[132:135]
    v_mfma_f32_16x16x32_bf16 v[128:131], v[164:167], v[212:215], v[128:131]
    v_mfma_f32_16x16x32_bf16 v[132:135], v[164:167], v[228:231], v[132:135]
    v_cvt_pk_bf16_f32 v112, v120, v121
    v_cvt_pk_bf16_f32 v113, v122, v123
    v_cvt_pk_bf16_f32 v114, v124, v125
    v_cvt_pk_bf16_f32 v115, v126, v127
    buffer_store_dwordx4 v[112:115], v8, s[16:19], 0 offen sc1
    v_add_u32 v8, 0x100000, v8
    s_waitcnt lgkmcnt(0)
    v_mfma_f32_16x16x32_bf16 v[120:123], v[136:139], v[200:203], 0
    v_mfma_f32_16x16x32_bf16 v[124:127], v[136:139], v[216:219], 0
    v_mfma_f32_16x16x32_bf16 v[120:123], v[140:143], v[204:207], v[120:123]
    v_mfma_f32_16x16x32_bf16 v[124:127], v[140:143], v[220:223], v[124:127]
    v_mfma_f32_16x16x32_bf16 v[120:123], v[144:147], v[208:211], v[120:123]
    v_mfma_f32_16x16x32_bf16 v[124:127], v[144:147], v[224:227], v[124:127]
    v_mfma_f32_16x16x32_bf16 v[120:123], v[148:151], v[212:215], v[120:123]
    v_mfma_f32_16x16x32_bf16 v[124:127], v[148:151], v[228:231], v[124:127]
    v_cvt_pk_bf16_f32 v116, v128, v129
    v_cvt_pk_bf16_f32 v117, v130, v131
    v_cvt_pk_bf16_f32 v118, v132, v133
    v_cvt_pk_bf16_f32 v119, v134, v135
    buffer_store_dwordx4 v[116:119], v8, s[16:19], 0 offen sc1
    v_add_u32 v8, 0x100000, v8
    s_nop 7
    v_cvt_pk_bf16_f32 v104, v120, v121
    v_cvt_pk_bf16_f32 v105, v122, v123
    v_cvt_pk_bf16_f32 v106, v124, v125
    v_cvt_pk_bf16_f32 v107, v126, v127
    buffer_store_dwordx4 v[104:107], v8, s[16:19], 0 offen sc1
K2_END:
    s_endpgm
K2_CODE_END:
    s_endpgm
.section .rodata,"a"
.p2align 6
.amdhsa_kernel bin_kernel
  .amdhsa_next_free_vgpr 44
  .amdhsa_next_free_sgpr 72
  .amdhsa_accum_offset 44
  .amdhsa_group_segment_fixed_size 0
  .amdhsa_kernarg_size 88
  .amdhsa_user_sgpr_count 2
  .amdhsa_user_sgpr_kernarg_segment_ptr 1
  .amdhsa_system_sgpr_workgroup_id_x 1
  .amdhsa_float_denorm_mode_32 3
.end_amdhsa_kernel
.p2align 6
.amdhsa_kernel main_kernel
  .amdhsa_next_free_vgpr 232
  .amdhsa_next_free_sgpr 80
  .amdhsa_accum_offset 232
  .amdhsa_group_segment_fixed_size 0
  .amdhsa_kernarg_size 88
  .amdhsa_user_sgpr_count 2
  .amdhsa_user_sgpr_kernarg_segment_ptr 1
  .amdhsa_system_sgpr_workgroup_id_x 1
  .amdhsa_float_denorm_mode_32 3
.end_amdhsa_kernel
```
